```python
import torch

def _softmax(x, axis=-1):
    return torch.softmax(x, dim=axis)
def _gelu(x):
    return torch.nn.functional.gelu(x, approximate="tanh")
def _silu(x):
    return torch.nn.functional.silu(x)
def _sigmoid(x):
    return torch.sigmoid(x)
def _layernorm(x, axis=-1, eps=1e-5):
    m = x.mean(dim=axis, keepdim=True)
    v = x.var(dim=axis, keepdim=True, unbiased=False)
    return (x - m) / torch.sqrt(v + eps)
def _scatter_add(tgt, idx, src, axis=0):
    return tgt.clone().index_add_(axis, idx, src)
def _segment_sum(src, seg, n):
    out = torch.zeros((n,) + src.shape[1:], dtype=src.dtype)
    return out.index_add_(0, seg, src)
def _pad(x, pw):
    flat = tuple(v for pair in reversed(pw) for v in pair)
    return torch.nn.functional.pad(x, flat)

kernel_name = 'standalone__fused_io_aware_attn__prompt'

def setup_inputs():

    _w = (lambda a: (lambda t: t.to(torch.bfloat16) if t.is_floating_point() else t)(torch.as_tensor(a)))
    B, H, S = 1, 16, 4096
    Dh = max(1, 448 // 16)
    return {
        "q": _w((lambda *s: torch.randn(*s, dtype=torch.bfloat16) * 0.8)(B, H, S, Dh)),
        "k": _w((lambda *s: torch.randn(*s, dtype=torch.bfloat16) * 0.8)(B, H, S, Dh)),
        "v": _w((lambda *s: torch.randn(*s, dtype=torch.bfloat16) * 0.05)(B, H, S, Dh)),
    }

def reference(q, k, v):
    scale = q.shape[-1] ** -0.5
    s = torch.einsum('bhqd,bhkd->bhqk', q, k) * scale
    p = _softmax(s, axis=-1)
    return torch.einsum('bhqk,bhkd->bhqd', p, v)
```

```asm
; @launch grid=(256,1,1) block=(512,1,1) lds=147712
.amdgcn_target "amdgcn-amd-amdhsa--gfx950"
.text
.globl standalone__fused_io_aware_attn__prompt_kernel
.p2align 12
.p2align 8
.type standalone__fused_io_aware_attn__prompt_kernel,@function
standalone__fused_io_aware_attn__prompt_kernel:
    s_load_dwordx2 s[12:13], s[0:1], 0
    v_lshrrev_b32 v4, 6, v0
    s_load_dwordx4 s[4:7], s[0:1], 8
    v_readfirstlane_b32 s28, v4
    s_cmpk_ge_u32 s2, 0x100
    s_cbranch_scc1 L_end
    s_getpc_b64 s[16:17]
L_pc:
    v_lshlrev_b32 v5, 4, v0
    v_min_u32 v6, L_end-L_pc, v5
    global_load_dword v23, v6, s[16:17]
    s_setprio 3
    s_mulk_i32 s2, 0x101
    s_and_b32 s50, s2, 0x7f8
    s_lshr_b32 s31, s50, 7
    s_add_u32 s50, s50, s28
    s_mulk_i32 s50, 1792
    s_mov_b32 s14, 3670016
    s_mov_b32 s15, 0x20000
    v_and_b32 v2, 31, v0
    v_and_b32 v3, 32, v0
    v_mul_u32_u24 v2, 56, v2
    v_add_u32 v9, v2, v3
    v_and_b32 v8, 0x3f0, v5
    s_mul_i32 s31, s31, 229376
    s_mul_i32 s39, s28, 7168
    s_and_b32 s38, s28, 3
    s_mulk_i32 s38, 7168
    s_add_u32 s46, s38, s31
    s_mov_b64 s[22:23], s[14:15]
    s_mov_b32 s34, s46
    s_mov_b32 m0, s39
    s_mov_b32 s40, 0
    s_cmp_lt_u32 s28, 4
    s_waitcnt lgkmcnt(0)
    s_cselect_b64 s[20:21], s[4:5], s[6:7]
    s_setprio 2
    s_cbranch_scc0 L_q1
    s_setprio 3
    buffer_load_dwordx4 v[56:59], v9, s[12:15], s50 offen
    buffer_load_dwordx4 v[60:63], v9, s[12:15], s50 offen offset:16
L_q1:
    buffer_load_dwordx4 v8, s[20:23], s34 offen lds
    buffer_load_dwordx4 v8, s[20:23], s34 offen offset:1024 lds
    s_setprio 2
    s_load_dwordx16 s[52:67], s[4:5], s31
    s_load_dwordx4 s[8:11], s[6:7], s31
    s_load_dwordx2 s[24:25], s[0:1], 24
    s_cbranch_scc1 L_q2
    buffer_load_dwordx4 v[56:59], v9, s[12:15], s50 offen
    buffer_load_dwordx4 v[60:63], v9, s[12:15], s50 offen offset:16
L_q2:
L_restart:
    s_setprio 0
    v_lshlrev_b32 v4, 11, v3
    v_mov_b32 v160, 0x3f80
    v_mov_b32 v161, 0
    v_mov_b32 v84, 0x4a804a80
    s_mov_b64 s[26:27], s[14:15]
    v_lshl_add_u32 v4, v2, 2, v4
    v_mov_b32 v6, 147456
    ds_write_b64 v4, v[160:161] offset:57568
    ds_write_b32 v6, v161
    v_add_u32 v10, s38, v9
    v_lshrrev_b32 v5, 3, v3
    v_mov_b32 v85, v84
    s_add_u32 s37, s38, 24
    v_add3_u32 v11, v2, v5, s37
    buffer_load_dwordx4 v8, s[20:23], s34 offen offset:2048 lds
    v_mov_b32 v71, 0x3f803f80
    s_add_u32 s37, s38, 28672
    v_mov_b32 v79, v71
    v_mul_u32_u24 v7, 14, v3
    v_and_b32 v4, 12, v0
    v_mad_u32_u24 v4, v4, 14, v7
    v_and_b32 v5, 3, v0
    v_lshl_add_u32 v4, v5, 3, v4
    v_mov_b64 v[86:87], v[84:85]
    s_mov_b32 vcc_lo, 0x88880000
    v_and_b32 v5, 16, v0
    v_lshl_add_u32 v4, v5, 1, v4
    s_mov_b32 vcc_hi, vcc_lo
    v_add_u32 v4, s37, v4
    v_add_u32 v7, 57568, v7
    v_cndmask_b32 v12, v4, v7, vcc
    s_lshl_b32 s37, s28, 11
    s_add_u32 s37, s37, 131072
    v_add_u32 v15, s37, v8
    v_mov_b32 v88, 0x7fff7fff
    s_mov_b32 vcc_lo, 0x0fffffff
    s_mov_b32 vcc_hi, vcc_lo
    buffer_load_dwordx4 v8, s[20:23], s34 offen offset:3072 lds
    v_cndmask_b32 v88, 0, v88, vcc
    v_xor_b32 v16, 2048, v15
    v_xor_b32 v17, 4096, v15
    v_xor_b32 v18, 6144, v15
    v_lshl_add_u32 v22, s28, 12, v8
    v_xor_b32 v19, 4096, v22
    v_xor_b32 v20, 8192, v22
    v_xor_b32 v21, 77824, v22
    v_or_b32 v1, 65536, v22
    v_lshrrev_b32 v4, 2, v3
    v_add3_u32 v14, v4, v2, s37
    v_mov_b32 v13, 0xdddddddd
    s_mov_b32 s43, 0xffff0000
    s_mov_b32 s42, 0x3e8b97f6
    s_mov_b32 s33, 0
    s_add_u32 m0, s39, 4096
    s_add_u32 s34, s46, 4096
    s_cmp_lg_u32 s40, 0
    s_cbranch_scc1 L_skipq
    v_mov_b32 v4, 0x41400000
    v_mov_b32 v5, 0x45800000
    v_mov_b32 v31, 0
    s_waitcnt lgkmcnt(0)
    v_mov_b64 v[24:25], s[52:53]
    v_mov_b64 v[26:27], s[54:55]
    v_mov_b64 v[28:29], s[56:57]
    v_mov_b32 v30, s58
    s_mov_b32 exec_lo, 0
    v_mov_b64 v[24:25], s[60:61]
    v_mov_b64 v[26:27], s[62:63]
    v_mov_b64 v[28:29], s[64:65]
    v_mov_b32 v30, s59
    s_mov_b32 exec_lo, -1
    v_and_b32 v80, s8, v88
    v_and_b32 v81, s9, v88
    v_and_b32 v82, s10, v88
    v_and_b32 v83, s11, v88
    s_nop 1
    v_mfma_f32_32x32x16_bf16 v[144:159], v[80:83], v[84:87], 0
    v_mfma_f32_32x32x16_bf16 v[96:111], v[80:83], v[84:87], 0
    v_mfma_f32_32x32x16_bf16 v[112:127], v[80:83], v[84:87], 0
    v_mfma_f32_32x32x16_bf16 v[128:143], v[80:83], v[84:87], 0
    s_cmp_lt_u32 s28, 4
    s_cbranch_scc1 L_a0
    s_setprio 3
    s_barrier
    s_waitcnt vmcnt(2)
    s_branch L_a0
    s_nop 0
    s_nop 0
    s_nop 0
    s_nop 0
    s_nop 0
L_first0:
    buffer_load_dwordx4 v8, s[20:23], s34 offen lds
    buffer_load_dwordx4 v8, s[20:23], s34 offen offset:1024 lds
    s_cmp_lt_u32 s28, 4
    s_cbranch_scc0 L_first0_ret
    s_waitcnt vmcnt(5)
    s_barrier
    ds_read_b64_tr_b16 v[80:81], v12 offset:0
    ds_read_b64_tr_b16 v[82:83], v12 offset:224
    ds_read_b64_tr_b16 v[84:85], v12 offset:896
    ds_read_b64_tr_b16 v[86:87], v12 offset:1120
    s_branch L_first0_ret
L_first1:
    s_waitcnt vmcnt(6)
    s_setprio 3
    s_mov_b64 vcc, 0
    s_barrier
    s_branch L_first1_ret
L_a0:
    s_waitcnt vmcnt(4)
    v_mfma_f32_32x32x16_bf16 v[192:207], v[24:27], v[56:59], 0
    v_permlane32_swap_b32 v62, v63
    v_lshlrev_b32 v168, 16, v56
    v_and_b32 v169, s43, v56
    v_lshlrev_b32 v170, 16, v57
    v_and_b32 v171, s43, v57
    v_lshlrev_b32 v172, 16, v58
    v_and_b32 v173, s43, v58
    v_mfma_f32_32x32x16_bf16 v[192:207], v[28:31], v[60:63], v[192:207]
    v_lshlrev_b32 v174, 16, v59
    v_and_b32 v175, s43, v59
    v_mul_f32 v168, s42, v168
    v_mul_f32 v169, s42, v169
    v_mul_f32 v170, s42, v170
    v_mul_f32 v171, s42, v171
    v_mul_f32 v172, s42, v172
    v_mul_f32 v173, s42, v173
    v_mul_f32 v174, s42, v174
    v_mul_f32 v175, s42, v175
    v_cvt_pk_bf16_f32 v56, v168, v169
    v_cvt_pk_bf16_f32 v57, v170, v171
    v_cvt_pk_bf16_f32 v58, v172, v173
    v_cvt_pk_bf16_f32 v59, v174, v175
    ds_write_b128 v15, v[56:59]
    v_lshlrev_b32 v176, 16, v60
    v_and_b32 v177, s43, v60
    v_lshlrev_b32 v178, 16, v61
    v_and_b32 v179, s43, v61
    v_lshlrev_b32 v180, 16, v62
    v_and_b32 v181, s43, v62
    v_fma_f32 v192, -v192, s42, v4
    v_add_f32 v192, 0x4dc00000, v192
    v_subrev_f32 v192, 0x4dc00000, v192
    v_add_f32 v192, 0x41700000, v192
    v_mul_f32 v176, s42, v176
    v_mul_f32 v177, s42, v177
    v_mul_f32 v178, s42, v178
    v_mul_f32 v179, s42, v179
    v_mul_f32 v180, s42, v180
    v_mul_f32 v181, s42, v181
    v_cvt_pk_bf16_f32 v63, v5, v192
    v_cvt_pk_bf16_f32 v60, v176, v177
    v_cvt_pk_bf16_f32 v61, v178, v179
    v_cvt_pk_bf16_f32 v62, v180, v181
    s_mov_b32 exec_lo, 0
    v_mov_b32 v63, 0xc580
    s_mov_b32 exec_lo, -1
L_wq:
    ds_write_b128 v15, v[60:63] offset:1024
    v_mul_f32 v225, -4.0, v144
    s_cbranch_scc1 L_a1
    s_waitcnt vmcnt(0)
L_a1:
    s_waitcnt vmcnt(2) lgkmcnt(0)
    s_barrier
    ds_read_b128 v[32:35], v16
    ds_read_b64 v[64:65], v10 offset:0
    ds_read_b64 v[66:67], v10 offset:8
    ds_read_b128 v[36:39], v16 offset:1024
    ds_read_b64 v[68:69], v10 offset:16
    ds_read_b32 v70, v11 offset:0
    buffer_load_dwordx4 v8, s[20:23], s34 offen lds
    ds_read_b128 v[40:43], v17
    ds_read_b128 v[44:47], v17 offset:1024
    s_waitcnt lgkmcnt(5)
    v_mfma_f32_32x32x16_bf16 v[160:175], v[64:67], v[32:35], 4.0
    ds_read_b128 v[48:51], v18
    ds_read_b64_tr_b16 v[80:81], v12 offset:0
    ds_read_b64_tr_b16 v[82:83], v12 offset:224
    s_waitcnt lgkmcnt(5)
    v_mfma_f32_32x32x16_bf16 v[160:175], v[68:71], v[36:39], v[160:175]
    ds_read_b128 v[52:55], v18 offset:1024
    ds_read_b64_tr_b16 v[84:85], v12 offset:896
    ds_read_b64_tr_b16 v[86:87], v12 offset:1120
    buffer_load_dwordx4 v8, s[20:23], s34 offen offset:1024 lds
    s_waitcnt lgkmcnt(6)
    v_mfma_f32_32x32x16_bf16 v[176:191], v[64:67], v[40:43], 4.0
    buffer_load_dwordx4 v8, s[20:23], s34 offen offset:2048 lds
    s_add_u32 s34, s46, 28672
    s_add_u32 s35, s39, 65536
    s_mov_b32 m0, s35
    s_nop 2
    v_exp_f32 v160, v160
    v_exp_f32 v161, v161
    v_mfma_f32_32x32x16_bf16 v[176:191], v[68:71], v[44:47], v[176:191]
L_loop:
    s_waitcnt lgkmcnt(0)
    v_exp_f32 v162, v162
    v_exp_f32 v163, v163
    v_exp_f32 v164, v164
    v_exp_f32 v165, v165
    v_mfma_f32_32x32x16_bf16 v[192:207], v[64:67], v[48:51], 4.0
    v_exp_f32 v166, v166
    v_exp_f32 v167, v167
    v_exp_f32 v168, v168
    v_exp_f32 v169, v169
    v_mfma_f32_32x32x16_bf16 v[208:223], v[64:67], v[56:59], 4.0
    v_exp_f32 v170, v170
    v_exp_f32 v171, v171
    v_exp_f32 v172, v172
    v_exp_f32 v173, v173
    v_mfma_f32_32x32x16_bf16 v[192:207], v[68:71], v[52:55], v[192:207]
    s_cbranch_vccnz L_first0
L_first0_ret:
    v_exp_f32 v174, v174
    v_exp_f32 v175, v175
    v_exp_f32 v176, v176
    v_exp_f32 v177, v177
    v_mfma_f32_32x32x16_bf16 v[208:223], v[68:71], v[60:63], v[208:223]
    s_waitcnt lgkmcnt(0)
    v_exp_f32 v178, v178
    v_exp_f32 v179, v179
    v_exp_f32 v180, v180
    v_exp_f32 v181, v181
    v_smfmac_f32_32x32x32_bf16 v[96:111], v[80:83], v[160:167], v13
    ds_read_b64 v[72:73], v10 offset:1792
    v_exp_f32 v182, v182
    v_exp_f32 v183, v183
    v_exp_f32 v184, v184
    v_exp_f32 v185, v185
    v_smfmac_f32_32x32x32_bf16 v[112:127], v[80:83], v[176:183], v13
    ds_read_b64 v[74:75], v10 offset:1800
    v_exp_f32 v186, v186
    v_exp_f32 v187, v187
    v_exp_f32 v188, v188
    v_exp_f32 v189, v189
    v_smfmac_f32_32x32x32_bf16 v[96:111], v[84:87], v[168:175], v13
    ds_read_b64 v[76:77], v10 offset:1808
    v_exp_f32 v190, v190
    v_exp_f32 v191, v191
    v_exp_f32 v192, v192
    v_exp_f32 v193, v193
    v_smfmac_f32_32x32x32_bf16 v[112:127], v[84:87], v[184:191], v13
    s_waitcnt lgkmcnt(1)
    ds_read_b32 v78, v11 offset:1792
    v_exp_f32 v194, v194
    v_exp_f32 v195, v195
    v_exp_f32 v196, v196
    v_exp_f32 v197, v197
    v_mfma_f32_32x32x16_bf16 v[160:175], v[72:75], v[32:35], 4.0
    ds_read_b64_tr_b16 v[88:89], v12 offset:1792
    v_exp_f32 v198, v198
    v_exp_f32 v199, v199
    v_exp_f32 v200, v200
    v_exp_f32 v201, v201
    v_mfma_f32_32x32x16_bf16 v[176:191], v[72:75], v[40:43], 4.0
    s_waitcnt lgkmcnt(1)
    ds_read_b64_tr_b16 v[90:91], v12 offset:2016
    v_exp_f32 v202, v202
    v_exp_f32 v203, v203
    v_exp_f32 v204, v204
    v_exp_f32 v205, v205
    v_mfma_f32_32x32x16_bf16 v[160:175], v[76:79], v[36:39], v[160:175]
    ds_read_b64_tr_b16 v[92:93], v12 offset:2688
    v_exp_f32 v206, v206
    v_exp_f32 v207, v207
    v_exp_f32 v208, v208
    v_exp_f32 v209, v209
    v_mfma_f32_32x32x16_bf16 v[176:191], v[76:79], v[44:47], v[176:191]
    ds_read_b64_tr_b16 v[94:95], v12 offset:2912
    v_exp_f32 v210, v210
    v_exp_f32 v211, v211
    v_exp_f32 v212, v212
    v_exp_f32 v213, v213
    v_smfmac_f32_32x32x32_bf16 v[128:143], v[80:83], v[192:199], v13
    buffer_load_dwordx4 v8, s[20:23], s34 offen offset:2048 lds
    v_exp_f32 v214, v214
    v_exp_f32 v215, v215
    v_exp_f32 v216, v216
    v_exp_f32 v217, v217
    v_smfmac_f32_32x32x32_bf16 v[144:159], v[80:83], v[208:215], v13
    v_exp_f32 v218, v218
    v_exp_f32 v219, v219
    v_exp_f32 v220, v220
    v_exp_f32 v221, v221
    v_smfmac_f32_32x32x32_bf16 v[128:143], v[84:87], v[200:207], v13
    buffer_load_dwordx4 v8, s[20:23], s34 offen offset:3072 lds
    v_exp_f32 v222, v222
    v_exp_f32 v223, v223
    v_exp_f32 v160, v160
    v_exp_f32 v161, v161
    v_smfmac_f32_32x32x32_bf16 v[144:159], v[84:87], v[216:223], v13
    s_waitcnt lgkmcnt(0)
    s_add_u32 m0, s35, 4096
    v_exp_f32 v162, v162
    v_exp_f32 v163, v163
    v_exp_f32 v164, v164
    v_exp_f32 v165, v165
    v_mfma_f32_32x32x16_bf16 v[192:207], v[72:75], v[48:51], 4.0
    s_addk_i32 s34, 4096
    v_exp_f32 v166, v166
    v_exp_f32 v167, v167
    v_exp_f32 v168, v168
    v_exp_f32 v169, v169
    v_mfma_f32_32x32x16_bf16 v[208:223], v[72:75], v[56:59], 4.0
    buffer_load_dwordx4 v8, s[20:23], s34 offen lds
    v_exp_f32 v170, v170
    v_exp_f32 v171, v171
    v_exp_f32 v172, v172
    v_exp_f32 v173, v173
    v_mfma_f32_32x32x16_bf16 v[192:207], v[76:79], v[52:55], v[192:207]
    buffer_load_dwordx4 v8, s[20:23], s34 offen offset:1024 lds
    v_exp_f32 v174, v174
    v_exp_f32 v175, v175
    v_exp_f32 v176, v176
    v_exp_f32 v177, v177
    v_mfma_f32_32x32x16_bf16 v[208:223], v[76:79], v[60:63], v[208:223]
    s_cbranch_vccnz L_first1
L_first1_ret:
    v_exp_f32 v178, v178
    v_exp_f32 v179, v179
    v_exp_f32 v180, v180
    v_exp_f32 v181, v181
    v_smfmac_f32_32x32x32_bf16 v[96:111], v[88:91], v[160:167], v13
    buffer_load_dwordx4 v8, s[20:23], s34 offen offset:2048 lds
    ds_read_b64 v[64:65], v10 offset:3584
    v_exp_f32 v182, v182
    v_exp_f32 v183, v183
    v_exp_f32 v184, v184
    v_exp_f32 v185, v185
    v_smfmac_f32_32x32x32_bf16 v[112:127], v[88:91], v[176:183], v13
    ds_read_b64 v[66:67], v10 offset:3592
    v_exp_f32 v186, v186
    v_exp_f32 v187, v187
    v_exp_f32 v188, v188
    v_exp_f32 v189, v189
    v_smfmac_f32_32x32x32_bf16 v[96:111], v[92:95], v[168:175], v13
    s_cmp_eq_u32 s33, 7
    ds_read_b64 v[68:69], v10 offset:3600
    v_exp_f32 v190, v190
    v_exp_f32 v191, v191
    v_exp_f32 v192, v192
    v_exp_f32 v193, v193
    v_smfmac_f32_32x32x32_bf16 v[112:127], v[92:95], v[184:191], v13
    s_waitcnt lgkmcnt(1)
    s_cbranch_scc1 L_tail
    ds_read_b32 v70, v11 offset:3584
    v_exp_f32 v194, v194
    v_exp_f32 v195, v195
    v_exp_f32 v196, v196
    v_exp_f32 v197, v197
    v_mfma_f32_32x32x16_bf16 v[160:175], v[64:67], v[32:35], 4.0
    ds_read_b64_tr_b16 v[80:81], v12 offset:3584
    v_exp_f32 v198, v198
    v_exp_f32 v199, v199
    v_exp_f32 v200, v200
    v_exp_f32 v201, v201
    v_mfma_f32_32x32x16_bf16 v[176:191], v[64:67], v[40:43], 4.0
    s_waitcnt lgkmcnt(1)
    ds_read_b64_tr_b16 v[82:83], v12 offset:3808
    v_exp_f32 v202, v202
    v_exp_f32 v203, v203
    v_exp_f32 v204, v204
    v_exp_f32 v205, v205
    v_mfma_f32_32x32x16_bf16 v[160:175], v[68:71], v[36:39], v[160:175]
    ds_read_b64_tr_b16 v[84:85], v12 offset:4480
    v_exp_f32 v206, v206
    v_exp_f32 v207, v207
    v_exp_f32 v208, v208
    v_exp_f32 v209, v209
    v_mfma_f32_32x32x16_bf16 v[176:191], v[68:71], v[44:47], v[176:191]
    ds_read_b64_tr_b16 v[86:87], v12 offset:4704
    v_exp_f32 v210, v210
    v_exp_f32 v211, v211
    v_exp_f32 v212, v212
    v_exp_f32 v213, v213
    v_smfmac_f32_32x32x32_bf16 v[128:143], v[88:91], v[192:199], v13
    v_exp_f32 v214, v214
    v_exp_f32 v215, v215
    v_exp_f32 v216, v216
    v_exp_f32 v217, v217
    v_smfmac_f32_32x32x32_bf16 v[144:159], v[88:91], v[208:215], v13
    v_exp_f32 v218, v218
    v_exp_f32 v219, v219
    v_exp_f32 v220, v220
    v_exp_f32 v221, v221
    v_smfmac_f32_32x32x32_bf16 v[128:143], v[92:95], v[200:207], v13
    v_exp_f32 v222, v222
    v_exp_f32 v223, v223
    v_exp_f32 v160, v160
    v_exp_f32 v161, v161
    v_smfmac_f32_32x32x32_bf16 v[144:159], v[92:95], v[216:223], v13
    s_waitcnt lgkmcnt(0)
    v_exp_f32 v162, v162
    v_exp_f32 v163, v163
    v_exp_f32 v164, v164
    v_exp_f32 v165, v165
    v_mfma_f32_32x32x16_bf16 v[192:207], v[64:67], v[48:51], 4.0
    s_addk_i32 s34, 24576
    v_exp_f32 v166, v166
    v_exp_f32 v167, v167
    v_exp_f32 v168, v168
    v_exp_f32 v169, v169
    v_mfma_f32_32x32x16_bf16 v[208:223], v[64:67], v[56:59], 4.0
    s_xor_b32 s35, s35, 65536
    v_exp_f32 v170, v170
    v_exp_f32 v171, v171
    v_exp_f32 v172, v172
    v_exp_f32 v173, v173
    v_mfma_f32_32x32x16_bf16 v[192:207], v[68:71], v[52:55], v[192:207]
    s_add_u32 s33, s33, 1
    v_exp_f32 v174, v174
    v_exp_f32 v175, v175
    v_exp_f32 v176, v176
    v_exp_f32 v177, v177
    v_mfma_f32_32x32x16_bf16 v[208:223], v[68:71], v[60:63], v[208:223]
    s_cmp_lt_u32 s33, 7
    v_exp_f32 v178, v178
    v_exp_f32 v179, v179
    v_exp_f32 v180, v180
    v_exp_f32 v181, v181
    v_smfmac_f32_32x32x32_bf16 v[96:111], v[80:83], v[160:167], v13
    s_cselect_b32 s22, s14, 0
    s_cselect_b32 s35, s35, 131072
    ds_read_b64 v[72:73], v10 offset:5376
    v_exp_f32 v182, v182
    v_exp_f32 v183, v183
    v_exp_f32 v184, v184
    v_exp_f32 v185, v185
    v_smfmac_f32_32x32x32_bf16 v[112:127], v[80:83], v[176:183], v13
    s_mov_b32 m0, s35
    ds_read_b64 v[74:75], v10 offset:5384
    v_exp_f32 v186, v186
    v_exp_f32 v187, v187
    v_exp_f32 v188, v188
    v_exp_f32 v189, v189
    v_smfmac_f32_32x32x32_bf16 v[96:111], v[84:87], v[168:175], v13
    ds_read_b64 v[76:77], v10 offset:5392
    v_exp_f32 v190, v190
    v_exp_f32 v191, v191
    v_exp_f32 v192, v192
    v_exp_f32 v193, v193
    v_smfmac_f32_32x32x32_bf16 v[112:127], v[84:87], v[184:191], v13
    s_waitcnt lgkmcnt(1)
    s_setprio 2
    ds_read_b32 v78, v11 offset:5376
    v_exp_f32 v194, v194
    v_exp_f32 v195, v195
    v_exp_f32 v196, v196
    v_exp_f32 v197, v197
    v_mfma_f32_32x32x16_bf16 v[160:175], v[72:75], v[32:35], 4.0
    ds_read_b64_tr_b16 v[88:89], v12 offset:5376
    v_exp_f32 v198, v198
    v_exp_f32 v199, v199
    v_exp_f32 v200, v200
    v_exp_f32 v201, v201
    v_mfma_f32_32x32x16_bf16 v[176:191], v[72:75], v[40:43], 4.0
    s_waitcnt lgkmcnt(1)
    ds_read_b64_tr_b16 v[90:91], v12 offset:5600
    v_exp_f32 v202, v202
    v_exp_f32 v203, v203
    v_exp_f32 v204, v204
    v_exp_f32 v205, v205
    v_xor_b32 v10, 65536, v10
    v_mfma_f32_32x32x16_bf16 v[160:175], v[76:79], v[36:39], v[160:175]
    ds_read_b64_tr_b16 v[92:93], v12 offset:6272
    v_exp_f32 v206, v206
    v_exp_f32 v207, v207
    v_exp_f32 v208, v208
    v_exp_f32 v209, v209
    v_mfma_f32_32x32x16_bf16 v[176:191], v[76:79], v[44:47], v[176:191]
    ds_read_b64_tr_b16 v[94:95], v12 offset:6496
    v_exp_f32 v210, v210
    v_exp_f32 v211, v211
    v_exp_f32 v212, v212
    v_exp_f32 v213, v213
    v_xor_b32 v11, 65536, v11
    v_smfmac_f32_32x32x32_bf16 v[128:143], v[80:83], v[192:199], v13
    v_exp_f32 v214, v214
    v_exp_f32 v215, v215
    v_exp_f32 v216, v216
    v_exp_f32 v217, v217
    v_smfmac_f32_32x32x32_bf16 v[144:159], v[80:83], v[208:215], v13
    v_exp_f32 v218, v218
    v_exp_f32 v219, v219
    v_exp_f32 v220, v220
    v_exp_f32 v221, v221
    v_smfmac_f32_32x32x32_bf16 v[128:143], v[84:87], v[200:207], v13
    v_exp_f32 v222, v222
    v_exp_f32 v223, v223
    v_exp_f32 v160, v160
    v_exp_f32 v161, v161
    v_smfmac_f32_32x32x32_bf16 v[144:159], v[84:87], v[216:223], v13
    s_waitcnt lgkmcnt(0)
    v_exp_f32 v162, v162
    v_exp_f32 v163, v163
    v_exp_f32 v164, v164
    v_exp_f32 v165, v165
    v_mfma_f32_32x32x16_bf16 v[192:207], v[72:75], v[48:51], 4.0
    s_setprio 1
    v_exp_f32 v166, v166
    v_exp_f32 v167, v167
    v_exp_f32 v168, v168
    v_exp_f32 v169, v169
    v_xor_b32 v12, 65536, v12
    v_mfma_f32_32x32x16_bf16 v[208:223], v[72:75], v[56:59], 4.0
    s_waitcnt vmcnt(0)
    v_exp_f32 v170, v170
    v_exp_f32 v171, v171
    v_exp_f32 v172, v172
    v_exp_f32 v173, v173
    v_mfma_f32_32x32x16_bf16 v[192:207], v[76:79], v[52:55], v[192:207]
    s_setprio 0
    v_exp_f32 v174, v174
    v_exp_f32 v175, v175
    v_exp_f32 v176, v176
    v_exp_f32 v177, v177
    v_mfma_f32_32x32x16_bf16 v[208:223], v[76:79], v[60:63], v[208:223]
    s_barrier
    v_exp_f32 v178, v178
    v_exp_f32 v179, v179
    v_exp_f32 v180, v180
    v_exp_f32 v181, v181
    v_smfmac_f32_32x32x32_bf16 v[96:111], v[88:91], v[160:167], v13
    s_setprio 3
    ds_read_b64 v[64:65], v10 offset:0
    v_exp_f32 v182, v182
    v_exp_f32 v183, v183
    v_exp_f32 v184, v184
    v_exp_f32 v185, v185
    v_smfmac_f32_32x32x32_bf16 v[112:127], v[88:91], v[176:183], v13
    ds_read_b64 v[66:67], v10 offset:8
    v_exp_f32 v186, v186
    v_exp_f32 v187, v187
    v_exp_f32 v188, v188
    v_exp_f32 v189, v189
    v_smfmac_f32_32x32x32_bf16 v[96:111], v[92:95], v[168:175], v13
    ds_read_b64 v[68:69], v10 offset:16
    v_exp_f32 v190, v190
    v_exp_f32 v191, v191
    v_exp_f32 v192, v192
    v_exp_f32 v193, v193
    v_smfmac_f32_32x32x32_bf16 v[112:127], v[92:95], v[184:191], v13
    s_waitcnt lgkmcnt(1)
    ds_read_b32 v70, v11 offset:0
    v_exp_f32 v194, v194
    v_exp_f32 v195, v195
    v_exp_f32 v196, v196
    v_exp_f32 v197, v197
    v_mfma_f32_32x32x16_bf16 v[160:175], v[64:67], v[32:35], 4.0
    ds_read_b64_tr_b16 v[80:81], v12 offset:0
    v_exp_f32 v198, v198
    v_exp_f32 v199, v199
    v_exp_f32 v200, v200
    v_exp_f32 v201, v201
    v_mfma_f32_32x32x16_bf16 v[176:191], v[64:67], v[40:43], 4.0
    s_waitcnt lgkmcnt(1)
    ds_read_b64_tr_b16 v[82:83], v12 offset:224
    v_exp_f32 v202, v202
    v_exp_f32 v203, v203
    v_exp_f32 v204, v204
    v_exp_f32 v205, v205
    v_mfma_f32_32x32x16_bf16 v[160:175], v[68:71], v[36:39], v[160:175]
    ds_read_b64_tr_b16 v[84:85], v12 offset:896
    v_exp_f32 v206, v206
    v_exp_f32 v207, v207
    v_exp_f32 v208, v208
    v_exp_f32 v209, v209
    v_mfma_f32_32x32x16_bf16 v[176:191], v[68:71], v[44:47], v[176:191]
    ds_read_b64_tr_b16 v[86:87], v12 offset:1120
    v_exp_f32 v210, v210
    v_exp_f32 v211, v211
    v_exp_f32 v212, v212
    v_exp_f32 v213, v213
    v_smfmac_f32_32x32x32_bf16 v[128:143], v[88:91], v[192:199], v13
    buffer_load_dwordx4 v8, s[20:23], s34 offen lds
    v_exp_f32 v214, v214
    v_exp_f32 v215, v215
    v_exp_f32 v216, v216
    v_exp_f32 v217, v217
    v_smfmac_f32_32x32x32_bf16 v[144:159], v[88:91], v[208:215], v13
    v_exp_f32 v218, v218
    v_exp_f32 v219, v219
    v_exp_f32 v220, v220
    v_exp_f32 v221, v221
    v_smfmac_f32_32x32x32_bf16 v[128:143], v[92:95], v[200:207], v13
    buffer_load_dwordx4 v8, s[20:23], s34 offen offset:1024 lds
    v_exp_f32 v222, v222
    v_exp_f32 v223, v223
    v_exp_f32 v160, v160
    v_exp_f32 v161, v161
    v_smfmac_f32_32x32x32_bf16 v[144:159], v[92:95], v[216:223], v13
    s_branch L_loop
L_tail:
    ds_read_b32 v70, v11 offset:3584
    ds_read_b64 v[72:73], v10 offset:5376
    ds_read_b64 v[74:75], v10 offset:5384
    v_exp_f32 v194, v194
    v_exp_f32 v195, v195
    v_mfma_f32_32x32x16_bf16 v[160:175], v[64:67], v[32:35], 4.0
    v_exp_f32 v196, v196
    v_exp_f32 v197, v197
    s_waitcnt lgkmcnt(2)
    v_mfma_f32_32x32x16_bf16 v[160:175], v[68:71], v[36:39], v[160:175]
    ds_read_b64 v[76:77], v10 offset:5392
    v_exp_f32 v198, v198
    v_exp_f32 v199, v199
    v_exp_f32 v200, v200
    v_exp_f32 v201, v201
    v_smfmac_f32_32x32x32_bf16 v[128:143], v[88:91], v[192:199], v13
    s_waitcnt lgkmcnt(1)
    s_setprio 2
    ds_read_b32 v78, v11 offset:5376
    ds_read_b64_tr_b16 v[80:81], v12 offset:3584
    v_exp_f32 v202, v202
    v_exp_f32 v203, v203
    v_exp_f32 v204, v204
    v_exp_f32 v205, v205
    v_mfma_f32_32x32x16_bf16 v[176:191], v[72:75], v[32:35], 4.0
    ds_read_b64_tr_b16 v[82:83], v12 offset:3808
    v_exp_f32 v206, v206
    v_exp_f32 v207, v207
    v_exp_f32 v160, v160
    v_exp_f32 v161, v161
    v_smfmac_f32_32x32x32_bf16 v[128:143], v[92:95], v[200:207], v13
    s_waitcnt lgkmcnt(2)
    ds_read_b64_tr_b16 v[84:85], v12 offset:4480
    v_exp_f32 v162, v162
    v_exp_f32 v163, v163
    v_mfma_f32_32x32x16_bf16 v[176:191], v[76:79], v[36:39], v[176:191]
    v_exp_f32 v164, v164
    v_exp_f32 v165, v165
    v_mfma_f32_32x32x16_bf16 v[192:207], v[64:67], v[40:43], 4.0
    s_waitcnt lgkmcnt(1)
    ds_read_b64_tr_b16 v[86:87], v12 offset:4704
    v_exp_f32 v166, v166
    v_exp_f32 v167, v167
    v_exp_f32 v168, v168
    v_exp_f32 v169, v169
    v_smfmac_f32_32x32x32_bf16 v[96:111], v[80:83], v[160:167], v13
    ds_read_b64_tr_b16 v[24:25], v12 offset:5376
    v_exp_f32 v170, v170
    v_exp_f32 v171, v171
    v_exp_f32 v172, v172
    v_exp_f32 v173, v173
    v_mfma_f32_32x32x16_bf16 v[192:207], v[68:71], v[44:47], v[192:207]
    s_waitcnt lgkmcnt(1)
    ds_read_b64_tr_b16 v[26:27], v12 offset:5600
    v_exp_f32 v174, v174
    v_exp_f32 v175, v175
    v_exp_f32 v176, v176
    v_exp_f32 v177, v177
    v_smfmac_f32_32x32x32_bf16 v[96:111], v[84:87], v[168:175], v13
    ds_read_b64_tr_b16 v[28:29], v12 offset:6272
    v_exp_f32 v178, v178
    v_exp_f32 v179, v179
    v_exp_f32 v180, v180
    v_exp_f32 v181, v181
    v_mfma_f32_32x32x16_bf16 v[160:175], v[72:75], v[40:43], 4.0
    s_waitcnt lgkmcnt(1)
    s_setprio 1
    ds_read_b64_tr_b16 v[30:31], v12 offset:6496
    v_exp_f32 v182, v182
    v_exp_f32 v183, v183
    v_exp_f32 v184, v184
    v_exp_f32 v185, v185
    v_smfmac_f32_32x32x32_bf16 v[96:111], v[24:27], v[176:183], v13
    v_exp_f32 v186, v186
    v_exp_f32 v187, v187
    v_exp_f32 v188, v188
    v_exp_f32 v189, v189
    v_mfma_f32_32x32x16_bf16 v[160:175], v[76:79], v[44:47], v[160:175]
    s_waitcnt lgkmcnt(0)
    s_setprio 0
    v_exp_f32 v190, v190
    v_exp_f32 v191, v191
    v_exp_f32 v192, v192
    v_exp_f32 v193, v193
    v_smfmac_f32_32x32x32_bf16 v[96:111], v[28:31], v[184:191], v13
    s_waitcnt vmcnt(0) lgkmcnt(0)
    s_barrier
    v_exp_f32 v194, v194
    v_exp_f32 v195, v195
    v_exp_f32 v196, v196
    v_exp_f32 v197, v197
    v_mfma_f32_32x32x16_bf16 v[176:191], v[64:67], v[48:51], 4.0
    s_setprio 2
    v_exp_f32 v198, v198
    v_exp_f32 v199, v199
    v_exp_f32 v200, v200
    v_exp_f32 v201, v201
    v_smfmac_f32_32x32x32_bf16 v[112:127], v[80:83], v[192:199], v13
    v_exp_f32 v202, v202
    v_exp_f32 v203, v203
    v_exp_f32 v204, v204
    v_exp_f32 v205, v205
    v_mfma_f32_32x32x16_bf16 v[176:191], v[68:71], v[52:55], v[176:191]
    ds_write_b128 v19, v[96:99] offset:0
    v_exp_f32 v206, v206
    v_exp_f32 v207, v207
    v_exp_f32 v160, v160
    v_exp_f32 v161, v161
    v_smfmac_f32_32x32x32_bf16 v[112:127], v[84:87], v[200:207], v13
    ds_write_b128 v19, v[100:103] offset:1024
    v_exp_f32 v162, v162
    v_exp_f32 v163, v163
    v_exp_f32 v164, v164
    v_exp_f32 v165, v165
    v_mfma_f32_32x32x16_bf16 v[192:207], v[72:75], v[48:51], 4.0
    s_setprio 1
    ds_write_b128 v19, v[104:107] offset:2048
    v_exp_f32 v166, v166
    v_exp_f32 v167, v167
    v_exp_f32 v168, v168
    v_exp_f32 v169, v169
    v_smfmac_f32_32x32x32_bf16 v[112:127], v[24:27], v[160:167], v13
    ds_write_b128 v19, v[108:111] offset:3072
    v_exp_f32 v170, v170
    v_exp_f32 v171, v171
    v_exp_f32 v172, v172
    v_exp_f32 v173, v173
    v_mfma_f32_32x32x16_bf16 v[192:207], v[76:79], v[52:55], v[192:207]
    s_setprio 0
    v_exp_f32 v174, v174
    v_exp_f32 v175, v175
    v_exp_f32 v176, v176
    v_exp_f32 v177, v177
    v_smfmac_f32_32x32x32_bf16 v[112:127], v[28:31], v[168:175], v13
    s_waitcnt lgkmcnt(0)
    s_barrier
    v_exp_f32 v178, v178
    v_exp_f32 v179, v179
    v_exp_f32 v180, v180
    v_exp_f32 v181, v181
    v_mfma_f32_32x32x16_bf16 v[160:175], v[64:67], v[56:59], 4.0
    s_setprio 2
    ds_read_b128 v[96:99], v22 offset:0
    ds_read_b128 v[100:103], v22 offset:1024
    v_exp_f32 v182, v182
    v_exp_f32 v183, v183
    v_exp_f32 v184, v184
    v_exp_f32 v185, v185
    v_smfmac_f32_32x32x32_bf16 v[128:143], v[80:83], v[176:183], v13
    ds_read_b128 v[104:107], v22 offset:2048
    ds_read_b128 v[108:111], v22 offset:3072
    v_exp_f32 v186, v186
    v_exp_f32 v187, v187
    v_exp_f32 v188, v188
    v_exp_f32 v189, v189
    v_mfma_f32_32x32x16_bf16 v[160:175], v[68:71], v[60:63], v[160:175]
    ds_write_b128 v20, v[112:115] offset:32768
    v_exp_f32 v190, v190
    v_exp_f32 v191, v191
    v_exp_f32 v192, v192
    v_exp_f32 v193, v193
    v_smfmac_f32_32x32x32_bf16 v[128:143], v[84:87], v[184:191], v13
    ds_write_b128 v20, v[116:119] offset:33792
    v_exp_f32 v194, v194
    v_exp_f32 v195, v195
    v_exp_f32 v196, v196
    v_exp_f32 v197, v197
    v_mfma_f32_32x32x16_bf16 v[176:191], v[72:75], v[56:59], 4.0
    s_setprio 1
    ds_write_b128 v20, v[120:123] offset:34816
    v_exp_f32 v198, v198
    v_exp_f32 v199, v199
    v_exp_f32 v200, v200
    v_exp_f32 v201, v201
    v_smfmac_f32_32x32x32_bf16 v[128:143], v[24:27], v[192:199], v13
    ds_write_b128 v20, v[124:127] offset:35840
    v_exp_f32 v202, v202
    v_exp_f32 v203, v203
    v_exp_f32 v204, v204
    v_exp_f32 v205, v205
    v_mfma_f32_32x32x16_bf16 v[176:191], v[76:79], v[60:63], v[176:191]
    s_setprio 0
    v_exp_f32 v206, v206
    v_exp_f32 v207, v207
    v_exp_f32 v208, v208
    v_exp_f32 v209, v209
    v_smfmac_f32_32x32x32_bf16 v[128:143], v[28:31], v[200:207], v13
    s_waitcnt lgkmcnt(0)
    s_barrier
    v_exp_f32 v210, v210
    v_exp_f32 v211, v211
    v_exp_f32 v212, v212
    v_exp_f32 v213, v213
    s_setprio 2
    ds_read_b128 v[112:115], v22 offset:32768
    ds_read_b128 v[116:119], v22 offset:33792
    v_exp_f32 v214, v214
    v_exp_f32 v215, v215
    v_exp_f32 v216, v216
    v_exp_f32 v217, v217
    v_smfmac_f32_32x32x32_bf16 v[144:159], v[88:91], v[208:215], v13
    ds_read_b128 v[120:123], v22 offset:34816
    ds_read_b128 v[124:127], v22 offset:35840
    v_exp_f32 v218, v218
    v_exp_f32 v219, v219
    v_exp_f32 v220, v220
    v_exp_f32 v221, v221
    ds_write_b128 v21, v[128:131] offset:0
    v_exp_f32 v222, v222
    v_exp_f32 v223, v223
    v_exp_f32 v160, v160
    v_exp_f32 v161, v161
    v_smfmac_f32_32x32x32_bf16 v[144:159], v[92:95], v[216:223], v13
    ds_write_b128 v21, v[132:135] offset:1024
    v_exp_f32 v162, v162
    v_exp_f32 v163, v163
    v_exp_f32 v164, v164
    v_exp_f32 v165, v165
    s_setprio 1
    ds_write_b128 v21, v[136:139] offset:2048
    v_exp_f32 v166, v166
    v_exp_f32 v167, v167
    v_exp_f32 v168, v168
    v_exp_f32 v169, v169
    v_smfmac_f32_32x32x32_bf16 v[144:159], v[80:83], v[160:167], v13
    ds_write_b128 v21, v[140:143] offset:3072
    v_exp_f32 v170, v170
    v_exp_f32 v171, v171
    v_exp_f32 v172, v172
    v_exp_f32 v173, v173
    s_setprio 0
    v_exp_f32 v174, v174
    v_exp_f32 v175, v175
    v_exp_f32 v176, v176
    v_exp_f32 v177, v177
    v_smfmac_f32_32x32x32_bf16 v[144:159], v[84:87], v[168:175], v13
    s_waitcnt lgkmcnt(0)
    s_barrier
    v_add_f32 v96, v96, v112
    v_add_f32 v97, v97, v113
    v_add_f32 v98, v98, v114
    v_add_f32 v99, v99, v115
    v_add_f32 v100, v100, v116
    v_add_f32 v101, v101, v117
    v_add_f32 v102, v102, v118
    v_add_f32 v103, v103, v119
    v_add_f32 v104, v104, v120
    v_add_f32 v105, v105, v121
    v_add_f32 v106, v106, v122
    v_add_f32 v107, v107, v123
    v_add_f32 v108, v108, v124
    v_add_f32 v109, v109, v125
    v_add_f32 v110, v110, v126
    v_add_f32 v111, v111, v127
    v_exp_f32 v178, v178
    v_exp_f32 v179, v179
    v_exp_f32 v180, v180
    v_exp_f32 v181, v181
    s_setprio 1
    ds_read_b128 v[192:195], v1 offset:0
    ds_read_b128 v[196:199], v1 offset:1024
    v_exp_f32 v182, v182
    v_exp_f32 v183, v183
    v_exp_f32 v184, v184
    v_exp_f32 v185, v185
    v_smfmac_f32_32x32x32_bf16 v[144:159], v[24:27], v[176:183], v13
    ds_read_b128 v[200:203], v1 offset:2048
    ds_read_b128 v[204:207], v1 offset:3072
    v_exp_f32 v186, v186
    v_exp_f32 v187, v187
    v_exp_f32 v188, v188
    v_exp_f32 v189, v189
    v_exp_f32 v190, v190
    v_exp_f32 v191, v191
    s_waitcnt lgkmcnt(0)
    v_add_f32 v96, v96, v192
    v_add_f32 v97, v97, v193
    v_smfmac_f32_32x32x32_bf16 v[144:159], v[28:31], v[184:191], v13
    v_add_f32 v98, v98, v194
    v_add_f32 v99, v99, v195
    v_add_f32 v100, v100, v196
    v_add_f32 v101, v101, v197
    v_add_f32 v102, v102, v198
    v_add_f32 v103, v103, v199
    v_add_f32 v104, v104, v200
    v_add_f32 v105, v105, v201
    v_add_f32 v106, v106, v202
    v_add_f32 v107, v107, v203
    v_add_f32 v108, v108, v204
    v_add_f32 v109, v109, v205
    v_add_f32 v110, v110, v206
    v_add_f32 v111, v111, v207
    v_pk_add_f32 v[156:157], v[156:157], v[108:109]
    v_mov_b32 v4, v156
    v_mov_b32 v6, v156
    v_pk_add_f32 v[158:159], v[158:159], v[110:111]
    v_pk_add_f32 v[144:145], v[144:145], v[96:97]
    v_permlane32_swap_b32 v4, v6
    v_pk_add_f32 v[146:147], v[146:147], v[98:99]
    v_rcp_f32 v4, v6
    v_pk_add_f32 v[148:149], v[148:149], v[100:101]
    v_pk_add_f32 v[150:151], v[150:151], v[102:103]
    v_mul_f32 v226, v225, v4
    v_pk_add_f32 v[152:153], v[152:153], v[104:105]
    v_pk_add_f32 v[154:155], v[154:155], v[106:107]
    v_pk_fma_f32 v[204:205], v[156:157], v[4:5], v[226:227] op_sel_hi:[1,0,0]
    v_pk_fma_f32 v[206:207], v[158:159], v[4:5], v[226:227] op_sel_hi:[1,0,0]
    v_cvt_pk_bf16_f32 v118, v204, v205
    v_cvt_pk_bf16_f32 v119, v206, v207
    ds_write_b64 v14, v[118:119] offset:48
    v_pk_fma_f32 v[192:193], v[144:145], v[4:5], v[226:227] op_sel_hi:[1,0,0]
    v_pk_fma_f32 v[194:195], v[146:147], v[4:5], v[226:227] op_sel_hi:[1,0,0]
    v_cvt_pk_bf16_f32 v112, v192, v193
    v_cvt_pk_bf16_f32 v113, v194, v195
    ds_write_b64 v14, v[112:113] offset:0
    v_pk_fma_f32 v[196:197], v[148:149], v[4:5], v[226:227] op_sel_hi:[1,0,0]
    v_pk_fma_f32 v[198:199], v[150:151], v[4:5], v[226:227] op_sel_hi:[1,0,0]
    v_cvt_pk_bf16_f32 v114, v196, v197
    v_cvt_pk_bf16_f32 v115, v198, v199
    ds_write_b64 v14, v[114:115] offset:16
    v_pk_fma_f32 v[200:201], v[152:153], v[4:5], v[226:227] op_sel_hi:[1,0,0]
    v_pk_fma_f32 v[202:203], v[154:155], v[4:5], v[226:227] op_sel_hi:[1,0,0]
    v_cvt_pk_bf16_f32 v116, v200, v201
    v_cvt_pk_bf16_f32 v117, v202, v203
    ds_write_b64 v14, v[116:117] offset:32
    ds_read_b128 v[120:123], v15
    ds_read_b128 v[124:127], v15 offset:1024
    s_waitcnt lgkmcnt(1)
    buffer_store_dwordx4 v[120:123], v8, s[24:27], s50 offen sc0 sc1 nt
    s_mov_b32 exec_hi, 0xffff
    s_waitcnt lgkmcnt(0)
    buffer_store_dwordx4 v[124:127], v8, s[24:27], s50 offen offset:1024 sc0 sc1 nt
    s_mov_b32 exec_hi, -1
    s_setprio 0
    s_cmp_lg_u32 s40, 0
    s_cbranch_scc1 L_end
    v_mov_b32 v7, 0
    v_cmp_nlt_f32 vcc, 0x3a000000, v6
    v_pk_fma_f32 v[6:7], v[144:145], 0, v[6:7]
    v_pk_fma_f32 v[6:7], v[146:147], 0, v[6:7]
    v_pk_fma_f32 v[6:7], v[148:149], 0, v[6:7]
    v_pk_fma_f32 v[6:7], v[150:151], 0, v[6:7]
    v_pk_fma_f32 v[6:7], v[152:153], 0, v[6:7]
    v_pk_fma_f32 v[6:7], v[154:155], 0, v[6:7]
    v_pk_fma_f32 v[6:7], v[156:157], 0, v[6:7]
    v_pk_fma_f32 v[6:7], v[158:159], 0, v[6:7]
    s_mov_b64 s[42:43], vcc
    v_max_f32 v4, abs(v192), abs(v193)
    v_max3_f32 v4, abs(v194), abs(v195), v4
    v_max3_f32 v4, abs(v196), abs(v197), v4
    v_max3_f32 v4, abs(v198), abs(v199), v4
    v_max3_f32 v4, abs(v200), abs(v201), v4
    v_max3_f32 v4, abs(v202), abs(v203), v4
    v_mul_f32 v4, 0x42800000, v4
    v_cmp_nge_f32 vcc, v4, abs(v226)
    v_add_f32 v7, v6, v7
    v_mov_b32 v5, 147456
    s_or_b64 s[42:43], vcc, s[42:43]
    v_cmp_ngt_f32 vcc, 0x7b800000, v7
    v_mov_b32 v6, 1
    s_nop 0
    s_or_b64 vcc, vcc, s[42:43]
    s_cbranch_scc0 L_noflag
    ds_write_b32 v5, v6
L_noflag:
    s_waitcnt lgkmcnt(0)
    s_barrier
    ds_read_b32 v6, v5
    s_waitcnt lgkmcnt(0)
    v_readfirstlane_b32 s37, v6
    s_nop 3
    s_cmp_lg_u32 s37, 0
    s_cbranch_scc1 L_fallback
L_end:
    s_endpgm
L_fallback:
    s_waitcnt vmcnt(0)
    s_barrier
    s_mov_b32 s40, 1
    s_mov_b32 s22, s14
    s_mov_b64 s[16:17], s[4:5]
    s_mov_b32 s18, s14
    s_mov_b32 s19, 0x20000
    s_mov_b32 s37, s31
    s_add_u32 s42, s31, 229376
    v_mov_b32 v192, 0xff800000
    v_mov_b32 v63, 0
L_max:
    buffer_load_dwordx4 v[24:27], v9, s[16:19], s37 offen
    buffer_load_dwordx4 v[28:31], v9, s[16:19], s37 offen offset:16
    s_waitcnt vmcnt(0)
    v_permlane32_swap_b32 v30, v31
    s_nop 1
    v_mov_b32 v31, 0
    s_nop 1
    v_mfma_f32_32x32x16_bf16 v[160:175], v[24:27], v[56:59], 4.0
    v_mfma_f32_32x32x16_bf16 v[160:175], v[28:31], v[60:63], v[160:175]
    s_nop 15
    v_max3_f32 v192, v160, v161, v192
    v_max3_f32 v192, v162, v163, v192
    v_max3_f32 v192, v164, v165, v192
    v_max3_f32 v192, v166, v167, v192
    v_max3_f32 v192, v168, v169, v192
    v_max3_f32 v192, v170, v171, v192
    v_max3_f32 v192, v172, v173, v192
    v_max3_f32 v192, v174, v175, v192
    s_add_u32 s37, s37, 1792
    s_cmp_lt_u32 s37, s42
    s_cbranch_scc1 L_max
    v_mov_b32 v7, v192
    s_nop 1
    v_permlane32_swap_b32 v7, v192
    s_nop 1
    v_max_f32 v7, v7, v192
    v_cvt_pk_bf16_f32 v4, -v7, 0
    v_lshlrev_b32 v5, 16, v4
    v_sub_f32 v5, -v7, v5
    v_cvt_pk_bf16_f32 v4, -v7, v5
    v_and_b32 v6, 0xffff0000, v4
    v_sub_f32 v5, v5, v6
    v_cvt_pk_bf16_f32 v5, v5, 0
    v_mov_b32 v63, v4
    s_mov_b32 exec_lo, 0
    v_mov_b32 v63, v5
    s_mov_b32 exec_lo, -1
    s_mov_b32 m0, s39
    s_mov_b32 s34, s46
    buffer_load_dwordx4 v8, s[20:23], s34 offen lds
    buffer_load_dwordx4 v8, s[20:23], s34 offen offset:1024 lds
    s_branch L_restart
L_skipq:
    s_waitcnt vmcnt(0) lgkmcnt(0)
    s_cmp_lt_u32 s28, 4
    s_cbranch_scc1 L_sk1
    s_barrier
L_sk1:
    v_mov_b64 v[80:81], 0
    v_mov_b64 v[82:83], 0
    s_nop 1
    v_mfma_f32_32x32x16_bf16 v[96:111], v[80:83], v[84:87], 0
    v_mfma_f32_32x32x16_bf16 v[112:127], v[80:83], v[84:87], 0
    v_mfma_f32_32x32x16_bf16 v[128:143], v[80:83], v[84:87], 0
    v_mfma_f32_32x32x16_bf16 v[144:159], v[80:83], v[84:87], 0
    s_nop 15
    ds_write_b128 v15, v[56:59]
    s_branch L_wq
.section .rodata,"a"
.p2align 6
.amdhsa_kernel standalone__fused_io_aware_attn__prompt_kernel
  .amdhsa_next_free_vgpr 232
  .amdhsa_next_free_sgpr 72
  .amdhsa_accum_offset 232
  .amdhsa_group_segment_fixed_size 0
  .amdhsa_kernarg_size 48
  .amdhsa_user_sgpr_count 2
  .amdhsa_user_sgpr_kernarg_segment_ptr 1
  .amdhsa_system_sgpr_workgroup_id_x 1
.end_amdhsa_kernel
```
